```python
import torch

def _softmax(x, axis=-1):
    return torch.softmax(x, dim=axis)
def _gelu(x):
    return torch.nn.functional.gelu(x, approximate="tanh")
def _silu(x):
    return torch.nn.functional.silu(x)
def _sigmoid(x):
    return torch.sigmoid(x)
def _layernorm(x, axis=-1, eps=1e-5):
    m = x.mean(dim=axis, keepdim=True)
    v = x.var(dim=axis, keepdim=True, unbiased=False)
    return (x - m) / torch.sqrt(v + eps)
def _scatter_add(tgt, idx, src, axis=0):
    return tgt.clone().index_add_(axis, idx, src)
def _segment_sum(src, seg, n):
    out = torch.zeros((n,) + src.shape[1:], dtype=src.dtype)
    return out.index_add_(0, seg, src)
def _pad(x, pw):
    flat = tuple(v for pair in reversed(pw) for v in pair)
    return torch.nn.functional.pad(x, flat)

kernel_name = 'standalone__batchnorm__sampling'

def setup_inputs():

    _w = (lambda a: (lambda t: t.to(torch.bfloat16) if t.is_floating_point() else t)(torch.as_tensor(a)))
    B, S, C = 1024, 4, 512
    K = 3
    return {
        "x": _w((lambda *s: torch.randn(*s, dtype=torch.bfloat16) * 0.05)(B, S, C)),
        "w": _w((lambda *s: torch.randn(*s, dtype=torch.bfloat16) * 0.05)(K, C, C) * (1.0 / (K * C) ** 0.5)),
        "mean": _w((lambda *s: torch.randn(*s, dtype=torch.bfloat16) * 0.05)(C) * 0.1),
        "var": _w(torch.abs((lambda *s: torch.randn(*s, dtype=torch.bfloat16) * 0.05)(C)) + 0.5),
        "g": _w((lambda *s: torch.randn(*s, dtype=torch.bfloat16) * 0.05)(C) + 1.0),
        "b": _w((lambda *s: torch.randn(*s, dtype=torch.bfloat16) * 0.05)(C) * 0.1),
    }

def reference(x, w, mean, var, g, b):
    K = 3
    P = K // 2
    S = x.shape[1]
    xp = _pad(x, ((0, 0), (P, P), (0, 0)))
    y = sum(torch.einsum('bsc,cd->bsd', xp[:, k:k + S, :], w[k]) for k in range(K))
    inv_std = 1.0 / torch.sqrt(var + 1e-5)
    y = (y - mean) * (g * inv_std) + b
    return _silu(y)
```

```asm
; @launch grid=(256,1,1) block=(512,1,1) lds=163840
.amdgcn_target "amdgcn-amd-amdhsa--gfx950"
.text
.globl standalone__batchnorm__sampling_kernel
.p2align 8
.type standalone__batchnorm__sampling_kernel,@function
standalone__batchnorm__sampling_kernel:
    s_load_dwordx16 s[36:51], s[0:1], 0
    s_cmp_ge_u32 s2, 256
    s_cbranch_scc1 L_end
    v_readfirstlane_b32 s23, v0
    s_bfe_u32 s22, s2, 0x20003
    s_and_b32 s20, s2, 3
    s_lshr_b32 s21, s2, 5
    s_lshl3_add_u32 s20, s20, s21
    s_and_b32 s21, s2, 4
    s_add_u32 s21, s21, s22
    v_and_b32 v1, 63, v0
    s_lshr_b32 s23, s23, 6
    s_cmp_ge_u32 s23, 4
    s_cbranch_scc1 L_consumer
    s_setprio 2
    s_add_u32 s35, s20, s21
    s_and_b32 s35, s35, 3
    s_mov_b32 s34, 0x64531720
    s_cmp_eq_u32 s35, 1
    s_cselect_b32 s34, 0x56437201, s34
    s_cmp_eq_u32 s35, 2
    s_cselect_b32 s34, 0x64175032, s34
    s_cmp_eq_u32 s35, 3
    s_cselect_b32 s34, 0x65470123, s34
    s_lshr_b32 s35, s2, 2
    s_xor_b32 s35, s35, s2
    s_bitcmp1_b32 s35, 0
    s_cselect_b32 s35, 0x44444444, 0
    s_add_u32 s34, s34, s35
    s_lshl_b32 s20, s20, 17
    s_lshl_b32 s21, s21, 7
    v_lshrrev_b32 v2, 3, v1
    v_and_b32 v3, 7, v1
    v_lshrrev_b32 v4, 4, v1
    v_and_b32 v5, 1, v4
    v_lshlrev_b32 v5, 1, v5
    s_and_b32 s24, s23, 1
    s_lshl_b32 s24, s24, 2
    v_xor_b32 v5, s24, v5
    v_xor_b32 v5, v5, v3
    v_lshlrev_b32 v5, 4, v5
    v_lshl_add_u32 v5, v2, 10, v5
    s_lshl_b32 s24, s23, 13
    v_add_u32 v14, s24, v5
    v_add_u32 v15, 0x80000, v14
    v_add_u32 v16, 0x100000, v14
    v_xor_b32 v4, v3, v4
    v_lshlrev_b32 v4, 4, v4
    v_lshl_add_u32 v4, v2, 12, v4
    s_lshl_b32 s26, s23, 10
    v_add_u32 v10, s26, v4
    v_xor_b32 v11, 64, v10
    v_add_u32 v11, 31744, v11
    v_add_u32 v12, 63488, v10
    v_add_u32 v13, 63488, v11
    s_lshl_b32 s25, s23, 12
    s_mov_b32 s10, 0x20000
    s_mov_b32 s11, 0x20000
    s_mov_b32 s15, 0x20000
    s_sub_u32 s14, 1572864, s21
    s_and_b32 s28, s34, 7
    s_lshl_b32 s27, s28, 7
    s_lshl_b32 s28, s28, 16
    s_add_u32 m0, s26, 65536
    s_waitcnt lgkmcnt(0)
    s_add_u32 s12, s38, s21
    s_addc_u32 s13, s39, 0
    s_add_u32 s8, s36, s20
    s_addc_u32 s9, s37, 0
    buffer_load_dwordx4 v14, s[12:15], s28 offen lds
    s_add_u32 m0, m0, 4096
    s_nop 0
    buffer_load_dwordx4 v15, s[12:15], s28 offen lds
    s_add_u32 m0, m0, 4096
    s_nop 0
    buffer_load_dwordx4 v16, s[12:15], s28 offen lds
    s_add_u32 m0, s25, 0
    s_nop 0
    buffer_load_dwordx4 v10, s[8:11], s27 offen lds
    buffer_load_dwordx4 v11, s[8:11], s27 offen offset:1024 lds
    buffer_load_dwordx4 v12, s[8:11], s27 offen offset:2048 lds
    buffer_load_dwordx4 v13, s[8:11], s27 offen offset:3072 lds
    s_add_u32 m0, s26, 77824
    s_bitset1_b32 s28, 15
    buffer_load_dwordx4 v14, s[12:15], s28 offen lds
    s_add_u32 m0, m0, 4096
    s_nop 0
    buffer_load_dwordx4 v15, s[12:15], s28 offen lds
    s_add_u32 m0, m0, 4096
    s_nop 0
    buffer_load_dwordx4 v16, s[12:15], s28 offen lds
    s_add_u32 m0, s26, 90112
    s_lshr_b32 s34, s34, 4
    s_and_b32 s28, s34, 7
    s_lshl_b32 s27, s28, 7
    s_lshl_b32 s28, s28, 16
    buffer_load_dwordx4 v14, s[12:15], s28 offen lds
    s_add_u32 m0, m0, 4096
    s_nop 0
    buffer_load_dwordx4 v15, s[12:15], s28 offen lds
    s_add_u32 m0, m0, 4096
    s_nop 0
    buffer_load_dwordx4 v16, s[12:15], s28 offen lds
    s_add_u32 m0, s25, 16384
    s_nop 0
    buffer_load_dwordx4 v10, s[8:11], s27 offen lds
    buffer_load_dwordx4 v11, s[8:11], s27 offen offset:1024 lds
    buffer_load_dwordx4 v12, s[8:11], s27 offen offset:2048 lds
    buffer_load_dwordx4 v13, s[8:11], s27 offen offset:3072 lds
    s_waitcnt vmcnt(10)
    s_barrier
    s_add_u32 m0, s26, 102400
    s_bitset1_b32 s28, 15
    buffer_load_dwordx4 v14, s[12:15], s28 offen lds
    s_add_u32 m0, m0, 4096
    s_nop 0
    buffer_load_dwordx4 v15, s[12:15], s28 offen lds
    s_add_u32 m0, m0, 4096
    s_nop 0
    buffer_load_dwordx4 v16, s[12:15], s28 offen lds
    s_waitcnt vmcnt(10)
    s_barrier
    s_add_u32 m0, s26, 114688
    s_lshr_b32 s34, s34, 4
    s_and_b32 s28, s34, 7
    s_lshl_b32 s27, s28, 7
    s_lshl_b32 s28, s28, 16
    buffer_load_dwordx4 v14, s[12:15], s28 offen lds
    s_add_u32 m0, m0, 4096
    s_nop 0
    buffer_load_dwordx4 v15, s[12:15], s28 offen lds
    s_add_u32 m0, m0, 4096
    s_nop 0
    buffer_load_dwordx4 v16, s[12:15], s28 offen lds
    s_add_u32 m0, s25, 32768
    s_nop 0
    buffer_load_dwordx4 v10, s[8:11], s27 offen lds
    buffer_load_dwordx4 v11, s[8:11], s27 offen offset:1024 lds
    buffer_load_dwordx4 v12, s[8:11], s27 offen offset:2048 lds
    buffer_load_dwordx4 v13, s[8:11], s27 offen offset:3072 lds
    s_waitcnt vmcnt(10)
    s_barrier
    s_add_u32 m0, s26, 126976
    s_bitset1_b32 s28, 15
    buffer_load_dwordx4 v14, s[12:15], s28 offen lds
    s_add_u32 m0, m0, 4096
    s_nop 0
    buffer_load_dwordx4 v15, s[12:15], s28 offen lds
    s_add_u32 m0, m0, 4096
    s_nop 0
    buffer_load_dwordx4 v16, s[12:15], s28 offen lds
    s_waitcnt vmcnt(10)
    s_barrier
    s_add_u32 m0, s26, 139264
    s_lshr_b32 s34, s34, 4
    s_and_b32 s28, s34, 7
    s_lshl_b32 s27, s28, 7
    s_lshl_b32 s28, s28, 16
    buffer_load_dwordx4 v14, s[12:15], s28 offen lds
    s_add_u32 m0, m0, 4096
    s_nop 0
    buffer_load_dwordx4 v15, s[12:15], s28 offen lds
    s_add_u32 m0, m0, 4096
    s_nop 0
    buffer_load_dwordx4 v16, s[12:15], s28 offen lds
    s_add_u32 m0, s25, 49152
    s_nop 0
    buffer_load_dwordx4 v10, s[8:11], s27 offen lds
    buffer_load_dwordx4 v11, s[8:11], s27 offen offset:1024 lds
    buffer_load_dwordx4 v12, s[8:11], s27 offen offset:2048 lds
    buffer_load_dwordx4 v13, s[8:11], s27 offen offset:3072 lds
    s_waitcnt vmcnt(10)
    s_barrier
    s_add_u32 m0, s26, 151552
    s_bitset1_b32 s28, 15
    buffer_load_dwordx4 v14, s[12:15], s28 offen lds
    s_add_u32 m0, m0, 4096
    s_nop 0
    buffer_load_dwordx4 v15, s[12:15], s28 offen lds
    s_add_u32 m0, m0, 4096
    s_nop 0
    buffer_load_dwordx4 v16, s[12:15], s28 offen lds
    s_waitcnt vmcnt(10)
    s_barrier
    s_add_u32 m0, s26, 65536
    s_lshr_b32 s34, s34, 4
    s_and_b32 s28, s34, 7
    s_lshl_b32 s27, s28, 7
    s_lshl_b32 s28, s28, 16
    buffer_load_dwordx4 v14, s[12:15], s28 offen lds
    s_add_u32 m0, m0, 4096
    s_nop 0
    buffer_load_dwordx4 v15, s[12:15], s28 offen lds
    s_add_u32 m0, m0, 4096
    s_nop 0
    buffer_load_dwordx4 v16, s[12:15], s28 offen lds
    s_add_u32 m0, s25, 0
    s_nop 0
    buffer_load_dwordx4 v10, s[8:11], s27 offen lds
    buffer_load_dwordx4 v11, s[8:11], s27 offen offset:1024 lds
    buffer_load_dwordx4 v12, s[8:11], s27 offen offset:2048 lds
    buffer_load_dwordx4 v13, s[8:11], s27 offen offset:3072 lds
    s_waitcnt vmcnt(10)
    s_barrier
    s_add_u32 m0, s26, 77824
    s_bitset1_b32 s28, 15
    buffer_load_dwordx4 v14, s[12:15], s28 offen lds
    s_add_u32 m0, m0, 4096
    s_nop 0
    buffer_load_dwordx4 v15, s[12:15], s28 offen lds
    s_add_u32 m0, m0, 4096
    s_nop 0
    buffer_load_dwordx4 v16, s[12:15], s28 offen lds
    s_waitcnt vmcnt(10)
    s_barrier
    s_add_u32 m0, s26, 90112
    s_lshr_b32 s34, s34, 4
    s_and_b32 s28, s34, 7
    s_lshl_b32 s27, s28, 7
    s_lshl_b32 s28, s28, 16
    buffer_load_dwordx4 v14, s[12:15], s28 offen lds
    s_add_u32 m0, m0, 4096
    s_nop 0
    buffer_load_dwordx4 v15, s[12:15], s28 offen lds
    s_add_u32 m0, m0, 4096
    s_nop 0
    buffer_load_dwordx4 v16, s[12:15], s28 offen lds
    s_add_u32 m0, s25, 16384
    s_nop 0
    buffer_load_dwordx4 v10, s[8:11], s27 offen lds
    buffer_load_dwordx4 v11, s[8:11], s27 offen offset:1024 lds
    buffer_load_dwordx4 v12, s[8:11], s27 offen offset:2048 lds
    buffer_load_dwordx4 v13, s[8:11], s27 offen offset:3072 lds
    s_waitcnt vmcnt(10)
    s_barrier
    s_add_u32 m0, s26, 102400
    s_bitset1_b32 s28, 15
    buffer_load_dwordx4 v14, s[12:15], s28 offen lds
    s_add_u32 m0, m0, 4096
    s_nop 0
    buffer_load_dwordx4 v15, s[12:15], s28 offen lds
    s_add_u32 m0, m0, 4096
    s_nop 0
    buffer_load_dwordx4 v16, s[12:15], s28 offen lds
    s_waitcnt vmcnt(10)
    s_barrier
    s_add_u32 m0, s26, 114688
    s_lshr_b32 s34, s34, 4
    s_and_b32 s28, s34, 7
    s_lshl_b32 s27, s28, 7
    s_lshl_b32 s28, s28, 16
    buffer_load_dwordx4 v14, s[12:15], s28 offen lds
    s_add_u32 m0, m0, 4096
    s_nop 0
    buffer_load_dwordx4 v15, s[12:15], s28 offen lds
    s_add_u32 m0, m0, 4096
    s_nop 0
    buffer_load_dwordx4 v16, s[12:15], s28 offen lds
    s_add_u32 m0, s25, 32768
    s_nop 0
    buffer_load_dwordx4 v10, s[8:11], s27 offen lds
    buffer_load_dwordx4 v11, s[8:11], s27 offen offset:1024 lds
    buffer_load_dwordx4 v12, s[8:11], s27 offen offset:2048 lds
    buffer_load_dwordx4 v13, s[8:11], s27 offen offset:3072 lds
    s_waitcnt vmcnt(10)
    s_barrier
    s_add_u32 m0, s26, 126976
    s_bitset1_b32 s28, 15
    buffer_load_dwordx4 v14, s[12:15], s28 offen lds
    s_add_u32 m0, m0, 4096
    s_nop 0
    buffer_load_dwordx4 v15, s[12:15], s28 offen lds
    s_add_u32 m0, m0, 4096
    s_nop 0
    buffer_load_dwordx4 v16, s[12:15], s28 offen lds
    s_waitcnt vmcnt(10)
    s_barrier
    s_add_u32 m0, s26, 139264
    s_lshr_b32 s34, s34, 4
    s_and_b32 s28, s34, 7
    s_lshl_b32 s27, s28, 7
    s_lshl_b32 s28, s28, 16
    buffer_load_dwordx4 v14, s[12:15], s28 offen lds
    s_add_u32 m0, m0, 4096
    s_nop 0
    buffer_load_dwordx4 v15, s[12:15], s28 offen lds
    s_add_u32 m0, m0, 4096
    s_nop 0
    buffer_load_dwordx4 v16, s[12:15], s28 offen lds
    s_add_u32 m0, s25, 49152
    s_nop 0
    buffer_load_dwordx4 v10, s[8:11], s27 offen lds
    buffer_load_dwordx4 v11, s[8:11], s27 offen offset:1024 lds
    buffer_load_dwordx4 v12, s[8:11], s27 offen offset:2048 lds
    buffer_load_dwordx4 v13, s[8:11], s27 offen offset:3072 lds
    s_waitcnt vmcnt(10)
    s_barrier
    s_add_u32 m0, s26, 151552
    s_bitset1_b32 s28, 15
    buffer_load_dwordx4 v14, s[12:15], s28 offen lds
    s_add_u32 m0, m0, 4096
    s_nop 0
    buffer_load_dwordx4 v15, s[12:15], s28 offen lds
    s_add_u32 m0, m0, 4096
    s_nop 0
    buffer_load_dwordx4 v16, s[12:15], s28 offen lds
    s_waitcnt vmcnt(10)
    s_barrier
    s_waitcnt vmcnt(3)
    s_barrier
    s_waitcnt vmcnt(0)
    s_barrier
    s_endpgm
L_consumer:
    s_and_b32 s24, s23, 1
    s_lshl_b32 s21, s21, 7
    s_lshl_b32 s26, s24, 6
    s_add_u32 s26, s26, s21
    s_waitcnt lgkmcnt(0)
    s_load_dwordx16 s[56:71], s[40:41], s26
    s_load_dwordx16 s[72:87], s[42:43], s26
    s_load_dwordx16 s[0:15], s[44:45], s26
    s_load_dwordx16 s[28:43], s[46:47], s26
    s_sub_u32 s23, s23, 4
    s_lshl_b32 s20, s20, 17
    s_lshr_b32 s25, s23, 1
    v_and_b32 v2, 15, v1
    v_lshrrev_b32 v3, 4, v1
    v_lshrrev_b32 v20, 1, v2
    v_xor_b32 v20, v20, v3
    v_lshlrev_b32 v20, 4, v20
    v_lshl_add_u32 v20, v2, 7, v20
    s_lshl_b32 s26, s25, 11
    v_add_u32 v4, s26, v20
    v_xor_b32 v5, 64, v4
    v_bfe_u32 v20, v1, 2, 2
    v_lshl_add_u32 v21, v3, 3, v20
    v_lshlrev_b32 v21, 7, v21
    v_and_b32 v20, 2, v20
    v_and_b32 v26, 1, v3
    v_xor_b32 v26, s24, v26
    v_lshl_or_b32 v20, v26, 2, v20
    v_bfe_u32 v26, v1, 1, 1
    v_or_b32 v20, v20, v26
    v_lshl_add_u32 v21, v20, 4, v21
    v_and_b32 v20, 1, v1
    v_lshl_add_u32 v21, v20, 3, v21
    v_add_u32 v6, 65536, v21
    v_xor_b32 v7, 32, v6
    v_add_u32 v12, 61440, v6
    v_add_u32 v13, 61440, v7
    v_lshlrev_b32 v19, 12, v2
    v_and_b32 v21, 1, v3
    v_lshl_add_u32 v19, v21, 5, v19
    v_lshrrev_b32 v21, 1, v3
    v_lshl_add_u32 v19, v21, 4, v19
    s_lshl_b32 s26, s24, 6
    s_lshl_b32 s27, s25, 16
    s_add_u32 s26, s26, s27
    v_add_u32 v19, s26, v19
    s_add_u32 s20, s20, s21
    s_sub_u32 s54, 4194304, s20
    s_mov_b32 s55, 0x20000
    s_mov_b32 s18, 0xbfb8aa3b
    s_mov_b32 s19, 0xbfb8aa3b
    s_add_u32 s52, s48, s20
    s_addc_u32 s53, s49, 0
    s_mov_b32 s50, 0xffff0000
    v_and_b32 v27, 1, v1
    v_xor_b32 v27, 1, v27
    v_lshlrev_b32 v27, 4, v27
    s_waitcnt lgkmcnt(0)
    s_lshl_b64 exec, 3, 0
    v_mov_b32 v22, s56
    v_mov_b32 v23, s72
    v_mov_b32 v24, s0
    v_mov_b32 v25, s28
    s_lshl_b64 exec, 3, 2
    v_mov_b32 v22, s57
    v_mov_b32 v23, s73
    v_mov_b32 v24, s1
    v_mov_b32 v25, s29
    s_lshl_b64 exec, 3, 16
    v_mov_b32 v22, s58
    v_mov_b32 v23, s74
    v_mov_b32 v24, s2
    v_mov_b32 v25, s30
    s_lshl_b64 exec, 3, 18
    v_mov_b32 v22, s59
    v_mov_b32 v23, s75
    v_mov_b32 v24, s3
    v_mov_b32 v25, s31
    s_lshl_b64 exec, 3, 32
    v_mov_b32 v22, s60
    v_mov_b32 v23, s76
    v_mov_b32 v24, s4
    v_mov_b32 v25, s32
    s_lshl_b64 exec, 3, 34
    v_mov_b32 v22, s61
    v_mov_b32 v23, s77
    v_mov_b32 v24, s5
    v_mov_b32 v25, s33
    s_lshl_b64 exec, 3, 48
    v_mov_b32 v22, s62
    v_mov_b32 v23, s78
    v_mov_b32 v24, s6
    v_mov_b32 v25, s34
    s_lshl_b64 exec, 3, 50
    v_mov_b32 v22, s63
    v_mov_b32 v23, s79
    v_mov_b32 v24, s7
    v_mov_b32 v25, s35
    s_lshl_b64 exec, 3, 4
    v_mov_b32 v22, s64
    v_mov_b32 v23, s80
    v_mov_b32 v24, s8
    v_mov_b32 v25, s36
    s_lshl_b64 exec, 3, 6
    v_mov_b32 v22, s65
    v_mov_b32 v23, s81
    v_mov_b32 v24, s9
    v_mov_b32 v25, s37
    s_lshl_b64 exec, 3, 20
    v_mov_b32 v22, s66
    v_mov_b32 v23, s82
    v_mov_b32 v24, s10
    v_mov_b32 v25, s38
    s_lshl_b64 exec, 3, 22
    v_mov_b32 v22, s67
    v_mov_b32 v23, s83
    v_mov_b32 v24, s11
    v_mov_b32 v25, s39
    s_lshl_b64 exec, 3, 36
    v_mov_b32 v22, s68
    v_mov_b32 v23, s84
    v_mov_b32 v24, s12
    v_mov_b32 v25, s40
    s_lshl_b64 exec, 3, 38
    v_mov_b32 v22, s69
    v_mov_b32 v23, s85
    v_mov_b32 v24, s13
    v_mov_b32 v25, s41
    s_lshl_b64 exec, 3, 52
    v_mov_b32 v22, s70
    v_mov_b32 v23, s86
    v_mov_b32 v24, s14
    v_mov_b32 v25, s42
    s_lshl_b64 exec, 3, 54
    v_mov_b32 v22, s71
    v_mov_b32 v23, s87
    v_mov_b32 v24, s15
    v_mov_b32 v25, s43
    s_mov_b64 exec, -1
    v_lshlrev_b32 v22, v27, v22
    v_lshlrev_b32 v23, v27, v23
    v_lshlrev_b32 v24, v27, v24
    v_lshlrev_b32 v25, v27, v25
    v_and_b32 v23, s50, v23
    v_add_f32 v23, 0x3727c5ac, v23
    v_cvt_pk_bf16_f32 v23, v23, v23
    v_and_b32 v23, s50, v23
    v_sqrt_f32 v23, v23
    v_and_b32 v24, s50, v24
    v_cvt_pk_bf16_f32 v23, v23, v23
    v_and_b32 v23, s50, v23
    v_rcp_f32 v23, v23
    v_and_b32 v22, s50, v22
    v_cvt_pk_bf16_f32 v23, v23, v23
    v_and_b32 v23, s50, v23
    v_and_b32 v25, s50, v25
    v_mul_f32 v23, v24, v23
    v_cvt_pk_bf16_f32 v23, v23, v23
    v_and_b32 v23, s50, v23
    v_fma_f32 v25, -v22, v23, v25
    v_mul_f32 v23, 0xbfb8aa3b, v23
    v_mul_f32 v25, 0xbfb8aa3b, v25
    s_nop 1
    v_mov_b32_dpp v144, v23 row_newbcast:0 row_mask:0xf bank_mask:0xf
    v_mov_b32_dpp v145, v23 row_newbcast:1 row_mask:0xf bank_mask:0xf
    v_mov_b32_dpp v146, v23 row_newbcast:2 row_mask:0xf bank_mask:0xf
    v_mov_b32_dpp v147, v23 row_newbcast:3 row_mask:0xf bank_mask:0xf
    v_mov_b32_dpp v148, v23 row_newbcast:4 row_mask:0xf bank_mask:0xf
    v_mov_b32_dpp v149, v23 row_newbcast:5 row_mask:0xf bank_mask:0xf
    v_mov_b32_dpp v150, v23 row_newbcast:6 row_mask:0xf bank_mask:0xf
    v_mov_b32_dpp v151, v23 row_newbcast:7 row_mask:0xf bank_mask:0xf
    v_mov_b32_dpp v152, v25 row_newbcast:0 row_mask:0xf bank_mask:0xf
    v_mov_b32_dpp v153, v25 row_newbcast:1 row_mask:0xf bank_mask:0xf
    v_mov_b32_dpp v154, v25 row_newbcast:2 row_mask:0xf bank_mask:0xf
    v_mov_b32_dpp v155, v25 row_newbcast:3 row_mask:0xf bank_mask:0xf
    v_mov_b32_dpp v156, v25 row_newbcast:4 row_mask:0xf bank_mask:0xf
    v_mov_b32_dpp v157, v25 row_newbcast:5 row_mask:0xf bank_mask:0xf
    v_mov_b32_dpp v158, v25 row_newbcast:6 row_mask:0xf bank_mask:0xf
    v_mov_b32_dpp v159, v25 row_newbcast:7 row_mask:0xf bank_mask:0xf
    s_barrier
    ds_read_b128 v[88:91], v4 offset:0
    ds_read_b64_tr_b16 v[72:73], v6 offset:4096
    ds_read_b64_tr_b16 v[74:75], v6 offset:4608
    ds_read_b128 v[92:95], v4 offset:4096
    ds_read_b64_tr_b16 v[80:81], v6 offset:8192
    ds_read_b64_tr_b16 v[82:83], v6 offset:8704
    ds_read_b64_tr_b16 v[76:77], v7 offset:4096
    ds_read_b64_tr_b16 v[78:79], v7 offset:4608
    ds_read_b64_tr_b16 v[84:85], v7 offset:8192
    ds_read_b64_tr_b16 v[86:87], v7 offset:8704
    ds_read_b64_tr_b16 v[64:65], v6 offset:0
    ds_read_b64_tr_b16 v[66:67], v6 offset:512
    ds_read_b128 v[96:99], v4 offset:8192
    ds_read_b64_tr_b16 v[68:69], v7 offset:0
    ds_read_b64_tr_b16 v[70:71], v7 offset:512
    ds_read_b128 v[100:103], v4 offset:12288
    s_waitcnt lgkmcnt(13)
    v_mfma_f32_16x16x32_bf16 v[32:35], v[72:75], v[88:91], 0
    s_waitcnt lgkmcnt(10)
    s_barrier
    v_mfma_f32_16x16x32_bf16 v[32:35], v[80:83], v[92:95], v[32:35]
    ds_read_b128 v[128:131], v5 offset:0
    s_waitcnt lgkmcnt(9)
    v_mfma_f32_16x16x32_bf16 v[36:39], v[76:79], v[88:91], 0
    ds_read_b64_tr_b16 v[112:113], v6 offset:16384
    s_waitcnt lgkmcnt(8)
    v_mfma_f32_16x16x32_bf16 v[36:39], v[84:87], v[92:95], v[36:39]
    ds_read_b64_tr_b16 v[114:115], v6 offset:16896
    s_waitcnt lgkmcnt(7)
    v_mfma_f32_16x16x32_bf16 v[40:43], v[64:67], v[88:91], 0
    ds_read_b128 v[132:135], v5 offset:4096
    v_mfma_f32_16x16x32_bf16 v[40:43], v[72:75], v[92:95], v[40:43]
    ds_read_b64_tr_b16 v[120:121], v6 offset:20480
    s_waitcnt lgkmcnt(8)
    v_mfma_f32_16x16x32_bf16 v[40:43], v[80:83], v[96:99], v[40:43]
    ds_read_b64_tr_b16 v[122:123], v6 offset:20992
    s_waitcnt lgkmcnt(7)
    v_mfma_f32_16x16x32_bf16 v[44:47], v[68:71], v[88:91], 0
    ds_read_b64_tr_b16 v[116:117], v7 offset:16384
    v_mfma_f32_16x16x32_bf16 v[44:47], v[76:79], v[92:95], v[44:47]
    ds_read_b64_tr_b16 v[118:119], v7 offset:16896
    v_mfma_f32_16x16x32_bf16 v[44:47], v[84:87], v[96:99], v[44:47]
    ds_read_b64_tr_b16 v[124:125], v7 offset:20480
    v_mfma_f32_16x16x32_bf16 v[48:51], v[64:67], v[92:95], 0
    ds_read_b64_tr_b16 v[126:127], v7 offset:20992
    v_mfma_f32_16x16x32_bf16 v[48:51], v[72:75], v[96:99], v[48:51]
    ds_read_b64_tr_b16 v[104:105], v6 offset:12288
    s_waitcnt lgkmcnt(11)
    v_mfma_f32_16x16x32_bf16 v[48:51], v[80:83], v[100:103], v[48:51]
    ds_read_b64_tr_b16 v[106:107], v6 offset:12800
    v_mfma_f32_16x16x32_bf16 v[52:55], v[68:71], v[92:95], 0
    ds_read_b128 v[136:139], v5 offset:8192
    v_mfma_f32_16x16x32_bf16 v[52:55], v[76:79], v[96:99], v[52:55]
    ds_read_b64_tr_b16 v[108:109], v7 offset:12288
    v_mfma_f32_16x16x32_bf16 v[52:55], v[84:87], v[100:103], v[52:55]
    ds_read_b64_tr_b16 v[110:111], v7 offset:12800
    v_mfma_f32_16x16x32_bf16 v[56:59], v[64:67], v[96:99], 0
    ds_read_b128 v[140:143], v5 offset:12288
    v_mfma_f32_16x16x32_bf16 v[56:59], v[72:75], v[100:103], v[56:59]
    v_mfma_f32_16x16x32_bf16 v[60:63], v[68:71], v[96:99], 0
    v_mfma_f32_16x16x32_bf16 v[60:63], v[76:79], v[100:103], v[60:63]
    s_waitcnt lgkmcnt(13)
    v_mfma_f32_16x16x32_bf16 v[32:35], v[112:115], v[128:131], v[32:35]
    s_waitcnt lgkmcnt(10)
    s_barrier
    v_mfma_f32_16x16x32_bf16 v[32:35], v[120:123], v[132:135], v[32:35]
    ds_read_b128 v[88:91], v4 offset:16384
    s_waitcnt lgkmcnt(9)
    v_mfma_f32_16x16x32_bf16 v[36:39], v[116:119], v[128:131], v[36:39]
    ds_read_b64_tr_b16 v[72:73], v6 offset:28672
    s_waitcnt lgkmcnt(8)
    v_mfma_f32_16x16x32_bf16 v[36:39], v[124:127], v[132:135], v[36:39]
    ds_read_b64_tr_b16 v[74:75], v6 offset:29184
    s_waitcnt lgkmcnt(7)
    v_mfma_f32_16x16x32_bf16 v[40:43], v[104:107], v[128:131], v[40:43]
    ds_read_b128 v[92:95], v4 offset:20480
    v_mfma_f32_16x16x32_bf16 v[40:43], v[112:115], v[132:135], v[40:43]
    ds_read_b64_tr_b16 v[80:81], v6 offset:32768
    s_waitcnt lgkmcnt(8)
    v_mfma_f32_16x16x32_bf16 v[40:43], v[120:123], v[136:139], v[40:43]
    ds_read_b64_tr_b16 v[82:83], v6 offset:33280
    s_waitcnt lgkmcnt(7)
    v_mfma_f32_16x16x32_bf16 v[44:47], v[108:111], v[128:131], v[44:47]
    ds_read_b64_tr_b16 v[76:77], v7 offset:28672
    v_mfma_f32_16x16x32_bf16 v[44:47], v[116:119], v[132:135], v[44:47]
    ds_read_b64_tr_b16 v[78:79], v7 offset:29184
    v_mfma_f32_16x16x32_bf16 v[44:47], v[124:127], v[136:139], v[44:47]
    ds_read_b64_tr_b16 v[84:85], v7 offset:32768
    v_mfma_f32_16x16x32_bf16 v[48:51], v[104:107], v[132:135], v[48:51]
    ds_read_b64_tr_b16 v[86:87], v7 offset:33280
    v_mfma_f32_16x16x32_bf16 v[48:51], v[112:115], v[136:139], v[48:51]
    ds_read_b64_tr_b16 v[64:65], v6 offset:24576
    s_waitcnt lgkmcnt(11)
    v_mfma_f32_16x16x32_bf16 v[48:51], v[120:123], v[140:143], v[48:51]
    ds_read_b64_tr_b16 v[66:67], v6 offset:25088
    v_mfma_f32_16x16x32_bf16 v[52:55], v[108:111], v[132:135], v[52:55]
    ds_read_b128 v[96:99], v4 offset:24576
    v_mfma_f32_16x16x32_bf16 v[52:55], v[116:119], v[136:139], v[52:55]
    ds_read_b64_tr_b16 v[68:69], v7 offset:24576
    v_mfma_f32_16x16x32_bf16 v[52:55], v[124:127], v[140:143], v[52:55]
    ds_read_b64_tr_b16 v[70:71], v7 offset:25088
    v_mfma_f32_16x16x32_bf16 v[56:59], v[104:107], v[136:139], v[56:59]
    ds_read_b128 v[100:103], v4 offset:28672
    v_mfma_f32_16x16x32_bf16 v[56:59], v[112:115], v[140:143], v[56:59]
    v_mfma_f32_16x16x32_bf16 v[60:63], v[108:111], v[136:139], v[60:63]
    v_mfma_f32_16x16x32_bf16 v[60:63], v[116:119], v[140:143], v[60:63]
    s_waitcnt lgkmcnt(13)
    v_mfma_f32_16x16x32_bf16 v[32:35], v[72:75], v[88:91], v[32:35]
    s_waitcnt lgkmcnt(10)
    s_barrier
    v_mfma_f32_16x16x32_bf16 v[32:35], v[80:83], v[92:95], v[32:35]
    ds_read_b128 v[128:131], v5 offset:16384
    s_waitcnt lgkmcnt(9)
    v_mfma_f32_16x16x32_bf16 v[36:39], v[76:79], v[88:91], v[36:39]
    ds_read_b64_tr_b16 v[112:113], v6 offset:40960
    s_waitcnt lgkmcnt(8)
    v_mfma_f32_16x16x32_bf16 v[36:39], v[84:87], v[92:95], v[36:39]
    ds_read_b64_tr_b16 v[114:115], v6 offset:41472
    s_waitcnt lgkmcnt(7)
    v_mfma_f32_16x16x32_bf16 v[40:43], v[64:67], v[88:91], v[40:43]
    ds_read_b128 v[132:135], v5 offset:20480
    v_mfma_f32_16x16x32_bf16 v[40:43], v[72:75], v[92:95], v[40:43]
    ds_read_b64_tr_b16 v[120:121], v6 offset:45056
    s_waitcnt lgkmcnt(8)
    v_mfma_f32_16x16x32_bf16 v[40:43], v[80:83], v[96:99], v[40:43]
    ds_read_b64_tr_b16 v[122:123], v6 offset:45568
    s_waitcnt lgkmcnt(7)
    v_mfma_f32_16x16x32_bf16 v[44:47], v[68:71], v[88:91], v[44:47]
    ds_read_b64_tr_b16 v[116:117], v7 offset:40960
    v_mfma_f32_16x16x32_bf16 v[44:47], v[76:79], v[92:95], v[44:47]
    ds_read_b64_tr_b16 v[118:119], v7 offset:41472
    v_mfma_f32_16x16x32_bf16 v[44:47], v[84:87], v[96:99], v[44:47]
    ds_read_b64_tr_b16 v[124:125], v7 offset:45056
    v_mfma_f32_16x16x32_bf16 v[48:51], v[64:67], v[92:95], v[48:51]
    ds_read_b64_tr_b16 v[126:127], v7 offset:45568
    v_mfma_f32_16x16x32_bf16 v[48:51], v[72:75], v[96:99], v[48:51]
    ds_read_b64_tr_b16 v[104:105], v6 offset:36864
    s_waitcnt lgkmcnt(11)
    v_mfma_f32_16x16x32_bf16 v[48:51], v[80:83], v[100:103], v[48:51]
    ds_read_b64_tr_b16 v[106:107], v6 offset:37376
    v_mfma_f32_16x16x32_bf16 v[52:55], v[68:71], v[92:95], v[52:55]
    ds_read_b128 v[136:139], v5 offset:24576
    v_mfma_f32_16x16x32_bf16 v[52:55], v[76:79], v[96:99], v[52:55]
    ds_read_b64_tr_b16 v[108:109], v7 offset:36864
    v_mfma_f32_16x16x32_bf16 v[52:55], v[84:87], v[100:103], v[52:55]
    ds_read_b64_tr_b16 v[110:111], v7 offset:37376
    v_mfma_f32_16x16x32_bf16 v[56:59], v[64:67], v[96:99], v[56:59]
    ds_read_b128 v[140:143], v5 offset:28672
    v_mfma_f32_16x16x32_bf16 v[56:59], v[72:75], v[100:103], v[56:59]
    v_mfma_f32_16x16x32_bf16 v[60:63], v[68:71], v[96:99], v[60:63]
    v_mfma_f32_16x16x32_bf16 v[60:63], v[76:79], v[100:103], v[60:63]
    s_waitcnt lgkmcnt(13)
    v_mfma_f32_16x16x32_bf16 v[32:35], v[112:115], v[128:131], v[32:35]
    s_waitcnt lgkmcnt(10)
    s_barrier
    v_mfma_f32_16x16x32_bf16 v[32:35], v[120:123], v[132:135], v[32:35]
    ds_read_b128 v[88:91], v4 offset:32768
    s_waitcnt lgkmcnt(9)
    v_mfma_f32_16x16x32_bf16 v[36:39], v[116:119], v[128:131], v[36:39]
    ds_read_b64_tr_b16 v[72:73], v6 offset:53248
    s_waitcnt lgkmcnt(8)
    v_mfma_f32_16x16x32_bf16 v[36:39], v[124:127], v[132:135], v[36:39]
    ds_read_b64_tr_b16 v[74:75], v6 offset:53760
    s_waitcnt lgkmcnt(7)
    v_mfma_f32_16x16x32_bf16 v[40:43], v[104:107], v[128:131], v[40:43]
    ds_read_b128 v[92:95], v4 offset:36864
    v_mfma_f32_16x16x32_bf16 v[40:43], v[112:115], v[132:135], v[40:43]
    ds_read_b64_tr_b16 v[80:81], v6 offset:57344
    s_waitcnt lgkmcnt(8)
    v_mfma_f32_16x16x32_bf16 v[40:43], v[120:123], v[136:139], v[40:43]
    ds_read_b64_tr_b16 v[82:83], v6 offset:57856
    s_waitcnt lgkmcnt(7)
    v_mfma_f32_16x16x32_bf16 v[44:47], v[108:111], v[128:131], v[44:47]
    ds_read_b64_tr_b16 v[76:77], v7 offset:53248
    v_mfma_f32_16x16x32_bf16 v[44:47], v[116:119], v[132:135], v[44:47]
    ds_read_b64_tr_b16 v[78:79], v7 offset:53760
    v_mfma_f32_16x16x32_bf16 v[44:47], v[124:127], v[136:139], v[44:47]
    ds_read_b64_tr_b16 v[84:85], v7 offset:57344
    v_mfma_f32_16x16x32_bf16 v[48:51], v[104:107], v[132:135], v[48:51]
    ds_read_b64_tr_b16 v[86:87], v7 offset:57856
    v_mfma_f32_16x16x32_bf16 v[48:51], v[112:115], v[136:139], v[48:51]
    ds_read_b64_tr_b16 v[64:65], v6 offset:49152
    s_waitcnt lgkmcnt(11)
    v_mfma_f32_16x16x32_bf16 v[48:51], v[120:123], v[140:143], v[48:51]
    ds_read_b64_tr_b16 v[66:67], v6 offset:49664
    v_mfma_f32_16x16x32_bf16 v[52:55], v[108:111], v[132:135], v[52:55]
    ds_read_b128 v[96:99], v4 offset:40960
    v_mfma_f32_16x16x32_bf16 v[52:55], v[116:119], v[136:139], v[52:55]
    ds_read_b64_tr_b16 v[68:69], v7 offset:49152
    v_mfma_f32_16x16x32_bf16 v[52:55], v[124:127], v[140:143], v[52:55]
    ds_read_b64_tr_b16 v[70:71], v7 offset:49664
    v_mfma_f32_16x16x32_bf16 v[56:59], v[104:107], v[136:139], v[56:59]
    ds_read_b128 v[100:103], v4 offset:45056
    v_mfma_f32_16x16x32_bf16 v[56:59], v[112:115], v[140:143], v[56:59]
    v_mfma_f32_16x16x32_bf16 v[60:63], v[108:111], v[136:139], v[60:63]
    v_mfma_f32_16x16x32_bf16 v[60:63], v[116:119], v[140:143], v[60:63]
    s_waitcnt lgkmcnt(13)
    v_mfma_f32_16x16x32_bf16 v[32:35], v[72:75], v[88:91], v[32:35]
    s_waitcnt lgkmcnt(10)
    s_barrier
    v_mfma_f32_16x16x32_bf16 v[32:35], v[80:83], v[92:95], v[32:35]
    ds_read_b128 v[128:131], v5 offset:32768
    s_waitcnt lgkmcnt(9)
    v_mfma_f32_16x16x32_bf16 v[36:39], v[76:79], v[88:91], v[36:39]
    ds_read_b64_tr_b16 v[112:113], v12 offset:4096
    s_waitcnt lgkmcnt(8)
    v_mfma_f32_16x16x32_bf16 v[36:39], v[84:87], v[92:95], v[36:39]
    ds_read_b64_tr_b16 v[114:115], v12 offset:4608
    s_waitcnt lgkmcnt(7)
    v_mfma_f32_16x16x32_bf16 v[40:43], v[64:67], v[88:91], v[40:43]
    ds_read_b128 v[132:135], v5 offset:36864
    v_mfma_f32_16x16x32_bf16 v[40:43], v[72:75], v[92:95], v[40:43]
    ds_read_b64_tr_b16 v[120:121], v12 offset:8192
    s_waitcnt lgkmcnt(8)
    v_mfma_f32_16x16x32_bf16 v[40:43], v[80:83], v[96:99], v[40:43]
    ds_read_b64_tr_b16 v[122:123], v12 offset:8704
    s_waitcnt lgkmcnt(7)
    v_mfma_f32_16x16x32_bf16 v[44:47], v[68:71], v[88:91], v[44:47]
    ds_read_b64_tr_b16 v[116:117], v13 offset:4096
    v_mfma_f32_16x16x32_bf16 v[44:47], v[76:79], v[92:95], v[44:47]
    ds_read_b64_tr_b16 v[118:119], v13 offset:4608
    v_mfma_f32_16x16x32_bf16 v[44:47], v[84:87], v[96:99], v[44:47]
    ds_read_b64_tr_b16 v[124:125], v13 offset:8192
    v_mfma_f32_16x16x32_bf16 v[48:51], v[64:67], v[92:95], v[48:51]
    ds_read_b64_tr_b16 v[126:127], v13 offset:8704
    v_mfma_f32_16x16x32_bf16 v[48:51], v[72:75], v[96:99], v[48:51]
    ds_read_b64_tr_b16 v[104:105], v12 offset:0
    s_waitcnt lgkmcnt(11)
    v_mfma_f32_16x16x32_bf16 v[48:51], v[80:83], v[100:103], v[48:51]
    ds_read_b64_tr_b16 v[106:107], v12 offset:512
    v_mfma_f32_16x16x32_bf16 v[52:55], v[68:71], v[92:95], v[52:55]
    ds_read_b128 v[136:139], v5 offset:40960
    v_mfma_f32_16x16x32_bf16 v[52:55], v[76:79], v[96:99], v[52:55]
    ds_read_b64_tr_b16 v[108:109], v13 offset:0
    v_mfma_f32_16x16x32_bf16 v[52:55], v[84:87], v[100:103], v[52:55]
    ds_read_b64_tr_b16 v[110:111], v13 offset:512
    v_mfma_f32_16x16x32_bf16 v[56:59], v[64:67], v[96:99], v[56:59]
    ds_read_b128 v[140:143], v5 offset:45056
    v_mfma_f32_16x16x32_bf16 v[56:59], v[72:75], v[100:103], v[56:59]
    v_mfma_f32_16x16x32_bf16 v[60:63], v[68:71], v[96:99], v[60:63]
    v_mfma_f32_16x16x32_bf16 v[60:63], v[76:79], v[100:103], v[60:63]
    s_waitcnt lgkmcnt(13)
    v_mfma_f32_16x16x32_bf16 v[32:35], v[112:115], v[128:131], v[32:35]
    s_waitcnt lgkmcnt(10)
    s_barrier
    v_mfma_f32_16x16x32_bf16 v[32:35], v[120:123], v[132:135], v[32:35]
    ds_read_b128 v[88:91], v4 offset:49152
    s_waitcnt lgkmcnt(9)
    v_mfma_f32_16x16x32_bf16 v[36:39], v[116:119], v[128:131], v[36:39]
    ds_read_b64_tr_b16 v[72:73], v12 offset:16384
    s_waitcnt lgkmcnt(8)
    v_mfma_f32_16x16x32_bf16 v[36:39], v[124:127], v[132:135], v[36:39]
    ds_read_b64_tr_b16 v[74:75], v12 offset:16896
    s_waitcnt lgkmcnt(7)
    v_mfma_f32_16x16x32_bf16 v[40:43], v[104:107], v[128:131], v[40:43]
    ds_read_b128 v[92:95], v4 offset:53248
    v_mfma_f32_16x16x32_bf16 v[40:43], v[112:115], v[132:135], v[40:43]
    ds_read_b64_tr_b16 v[80:81], v12 offset:20480
    s_waitcnt lgkmcnt(8)
    v_mfma_f32_16x16x32_bf16 v[40:43], v[120:123], v[136:139], v[40:43]
    ds_read_b64_tr_b16 v[82:83], v12 offset:20992
    s_waitcnt lgkmcnt(7)
    v_mfma_f32_16x16x32_bf16 v[44:47], v[108:111], v[128:131], v[44:47]
    ds_read_b64_tr_b16 v[76:77], v13 offset:16384
    v_mfma_f32_16x16x32_bf16 v[44:47], v[116:119], v[132:135], v[44:47]
    ds_read_b64_tr_b16 v[78:79], v13 offset:16896
    v_mfma_f32_16x16x32_bf16 v[44:47], v[124:127], v[136:139], v[44:47]
    ds_read_b64_tr_b16 v[84:85], v13 offset:20480
    v_mfma_f32_16x16x32_bf16 v[48:51], v[104:107], v[132:135], v[48:51]
    ds_read_b64_tr_b16 v[86:87], v13 offset:20992
    v_mfma_f32_16x16x32_bf16 v[48:51], v[112:115], v[136:139], v[48:51]
    ds_read_b64_tr_b16 v[64:65], v12 offset:12288
    s_waitcnt lgkmcnt(11)
    v_mfma_f32_16x16x32_bf16 v[48:51], v[120:123], v[140:143], v[48:51]
    ds_read_b64_tr_b16 v[66:67], v12 offset:12800
    v_mfma_f32_16x16x32_bf16 v[52:55], v[108:111], v[132:135], v[52:55]
    ds_read_b128 v[96:99], v4 offset:57344
    v_mfma_f32_16x16x32_bf16 v[52:55], v[116:119], v[136:139], v[52:55]
    ds_read_b64_tr_b16 v[68:69], v13 offset:12288
    v_mfma_f32_16x16x32_bf16 v[52:55], v[124:127], v[140:143], v[52:55]
    ds_read_b64_tr_b16 v[70:71], v13 offset:12800
    v_mfma_f32_16x16x32_bf16 v[56:59], v[104:107], v[136:139], v[56:59]
    ds_read_b128 v[100:103], v4 offset:61440
    v_mfma_f32_16x16x32_bf16 v[56:59], v[112:115], v[140:143], v[56:59]
    v_mfma_f32_16x16x32_bf16 v[60:63], v[108:111], v[136:139], v[60:63]
    v_mfma_f32_16x16x32_bf16 v[60:63], v[116:119], v[140:143], v[60:63]
    s_waitcnt lgkmcnt(13)
    v_mfma_f32_16x16x32_bf16 v[32:35], v[72:75], v[88:91], v[32:35]
    s_waitcnt lgkmcnt(10)
    s_barrier
    v_mfma_f32_16x16x32_bf16 v[32:35], v[80:83], v[92:95], v[32:35]
    ds_read_b128 v[128:131], v5 offset:49152
    s_waitcnt lgkmcnt(9)
    v_mfma_f32_16x16x32_bf16 v[36:39], v[76:79], v[88:91], v[36:39]
    ds_read_b64_tr_b16 v[112:113], v12 offset:28672
    s_waitcnt lgkmcnt(8)
    v_mfma_f32_16x16x32_bf16 v[36:39], v[84:87], v[92:95], v[36:39]
    ds_read_b64_tr_b16 v[114:115], v12 offset:29184
    s_waitcnt lgkmcnt(7)
    v_mfma_f32_16x16x32_bf16 v[40:43], v[64:67], v[88:91], v[40:43]
    ds_read_b128 v[132:135], v5 offset:53248
    v_mfma_f32_16x16x32_bf16 v[40:43], v[72:75], v[92:95], v[40:43]
    ds_read_b64_tr_b16 v[120:121], v12 offset:32768
    s_waitcnt lgkmcnt(8)
    v_mfma_f32_16x16x32_bf16 v[40:43], v[80:83], v[96:99], v[40:43]
    ds_read_b64_tr_b16 v[122:123], v12 offset:33280
    s_waitcnt lgkmcnt(7)
    v_mfma_f32_16x16x32_bf16 v[44:47], v[68:71], v[88:91], v[44:47]
    ds_read_b64_tr_b16 v[116:117], v13 offset:28672
    v_mfma_f32_16x16x32_bf16 v[44:47], v[76:79], v[92:95], v[44:47]
    ds_read_b64_tr_b16 v[118:119], v13 offset:29184
    v_mfma_f32_16x16x32_bf16 v[44:47], v[84:87], v[96:99], v[44:47]
    ds_read_b64_tr_b16 v[124:125], v13 offset:32768
    v_mfma_f32_16x16x32_bf16 v[48:51], v[64:67], v[92:95], v[48:51]
    ds_read_b64_tr_b16 v[126:127], v13 offset:33280
    v_mfma_f32_16x16x32_bf16 v[48:51], v[72:75], v[96:99], v[48:51]
    ds_read_b64_tr_b16 v[104:105], v12 offset:24576
    s_waitcnt lgkmcnt(11)
    v_mfma_f32_16x16x32_bf16 v[48:51], v[80:83], v[100:103], v[48:51]
    ds_read_b64_tr_b16 v[106:107], v12 offset:25088
    v_mfma_f32_16x16x32_bf16 v[52:55], v[68:71], v[92:95], v[52:55]
    ds_read_b128 v[136:139], v5 offset:57344
    v_mfma_f32_16x16x32_bf16 v[52:55], v[76:79], v[96:99], v[52:55]
    ds_read_b64_tr_b16 v[108:109], v13 offset:24576
    v_mfma_f32_16x16x32_bf16 v[52:55], v[84:87], v[100:103], v[52:55]
    ds_read_b64_tr_b16 v[110:111], v13 offset:25088
    v_mfma_f32_16x16x32_bf16 v[56:59], v[64:67], v[96:99], v[56:59]
    ds_read_b128 v[140:143], v5 offset:61440
    v_mfma_f32_16x16x32_bf16 v[56:59], v[72:75], v[100:103], v[56:59]
    v_mfma_f32_16x16x32_bf16 v[60:63], v[68:71], v[96:99], v[60:63]
    v_mfma_f32_16x16x32_bf16 v[60:63], v[76:79], v[100:103], v[60:63]
    s_waitcnt lgkmcnt(13)
    v_mfma_f32_16x16x32_bf16 v[32:35], v[112:115], v[128:131], v[32:35]
    s_waitcnt lgkmcnt(10)
    s_barrier
    v_mfma_f32_16x16x32_bf16 v[32:35], v[120:123], v[132:135], v[32:35]
    ds_read_b128 v[88:91], v4 offset:0
    s_waitcnt lgkmcnt(9)
    v_mfma_f32_16x16x32_bf16 v[36:39], v[116:119], v[128:131], v[36:39]
    ds_read_b64_tr_b16 v[72:73], v6 offset:4096
    s_waitcnt lgkmcnt(8)
    v_mfma_f32_16x16x32_bf16 v[36:39], v[124:127], v[132:135], v[36:39]
    ds_read_b64_tr_b16 v[74:75], v6 offset:4608
    s_waitcnt lgkmcnt(7)
    v_mfma_f32_16x16x32_bf16 v[40:43], v[104:107], v[128:131], v[40:43]
    ds_read_b128 v[92:95], v4 offset:4096
    v_mfma_f32_16x16x32_bf16 v[40:43], v[112:115], v[132:135], v[40:43]
    ds_read_b64_tr_b16 v[80:81], v6 offset:8192
    s_waitcnt lgkmcnt(8)
    v_mfma_f32_16x16x32_bf16 v[40:43], v[120:123], v[136:139], v[40:43]
    ds_read_b64_tr_b16 v[82:83], v6 offset:8704
    s_waitcnt lgkmcnt(7)
    v_mfma_f32_16x16x32_bf16 v[44:47], v[108:111], v[128:131], v[44:47]
    ds_read_b64_tr_b16 v[76:77], v7 offset:4096
    v_mfma_f32_16x16x32_bf16 v[44:47], v[116:119], v[132:135], v[44:47]
    ds_read_b64_tr_b16 v[78:79], v7 offset:4608
    v_mfma_f32_16x16x32_bf16 v[44:47], v[124:127], v[136:139], v[44:47]
    ds_read_b64_tr_b16 v[84:85], v7 offset:8192
    v_mfma_f32_16x16x32_bf16 v[48:51], v[104:107], v[132:135], v[48:51]
    ds_read_b64_tr_b16 v[86:87], v7 offset:8704
    v_mfma_f32_16x16x32_bf16 v[48:51], v[112:115], v[136:139], v[48:51]
    ds_read_b64_tr_b16 v[64:65], v6 offset:0
    s_waitcnt lgkmcnt(11)
    v_mfma_f32_16x16x32_bf16 v[48:51], v[120:123], v[140:143], v[48:51]
    ds_read_b64_tr_b16 v[66:67], v6 offset:512
    v_mfma_f32_16x16x32_bf16 v[52:55], v[108:111], v[132:135], v[52:55]
    ds_read_b128 v[96:99], v4 offset:8192
    v_mfma_f32_16x16x32_bf16 v[52:55], v[116:119], v[136:139], v[52:55]
    ds_read_b64_tr_b16 v[68:69], v7 offset:0
    v_mfma_f32_16x16x32_bf16 v[52:55], v[124:127], v[140:143], v[52:55]
    ds_read_b64_tr_b16 v[70:71], v7 offset:512
    v_mfma_f32_16x16x32_bf16 v[56:59], v[104:107], v[136:139], v[56:59]
    ds_read_b128 v[100:103], v4 offset:12288
    v_mfma_f32_16x16x32_bf16 v[56:59], v[112:115], v[140:143], v[56:59]
    v_mfma_f32_16x16x32_bf16 v[60:63], v[108:111], v[136:139], v[60:63]
    v_mfma_f32_16x16x32_bf16 v[60:63], v[116:119], v[140:143], v[60:63]
    s_waitcnt lgkmcnt(13)
    v_mfma_f32_16x16x32_bf16 v[32:35], v[72:75], v[88:91], v[32:35]
    s_waitcnt lgkmcnt(10)
    s_barrier
    v_mfma_f32_16x16x32_bf16 v[32:35], v[80:83], v[92:95], v[32:35]
    ds_read_b128 v[128:131], v5 offset:0
    s_waitcnt lgkmcnt(9)
    v_mfma_f32_16x16x32_bf16 v[36:39], v[76:79], v[88:91], v[36:39]
    ds_read_b64_tr_b16 v[112:113], v6 offset:16384
    s_waitcnt lgkmcnt(8)
    v_mfma_f32_16x16x32_bf16 v[36:39], v[84:87], v[92:95], v[36:39]
    ds_read_b64_tr_b16 v[114:115], v6 offset:16896
    s_waitcnt lgkmcnt(7)
    v_mfma_f32_16x16x32_bf16 v[40:43], v[64:67], v[88:91], v[40:43]
    ds_read_b128 v[132:135], v5 offset:4096
    v_mfma_f32_16x16x32_bf16 v[40:43], v[72:75], v[92:95], v[40:43]
    ds_read_b64_tr_b16 v[120:121], v6 offset:20480
    s_waitcnt lgkmcnt(8)
    v_mfma_f32_16x16x32_bf16 v[40:43], v[80:83], v[96:99], v[40:43]
    ds_read_b64_tr_b16 v[122:123], v6 offset:20992
    s_waitcnt lgkmcnt(7)
    v_mfma_f32_16x16x32_bf16 v[44:47], v[68:71], v[88:91], v[44:47]
    ds_read_b64_tr_b16 v[116:117], v7 offset:16384
    v_mfma_f32_16x16x32_bf16 v[44:47], v[76:79], v[92:95], v[44:47]
    ds_read_b64_tr_b16 v[118:119], v7 offset:16896
    v_mfma_f32_16x16x32_bf16 v[44:47], v[84:87], v[96:99], v[44:47]
    ds_read_b64_tr_b16 v[124:125], v7 offset:20480
    v_mfma_f32_16x16x32_bf16 v[48:51], v[64:67], v[92:95], v[48:51]
    ds_read_b64_tr_b16 v[126:127], v7 offset:20992
    v_mfma_f32_16x16x32_bf16 v[48:51], v[72:75], v[96:99], v[48:51]
    ds_read_b64_tr_b16 v[104:105], v6 offset:12288
    s_waitcnt lgkmcnt(11)
    v_mfma_f32_16x16x32_bf16 v[48:51], v[80:83], v[100:103], v[48:51]
    ds_read_b64_tr_b16 v[106:107], v6 offset:12800
    v_mfma_f32_16x16x32_bf16 v[52:55], v[68:71], v[92:95], v[52:55]
    ds_read_b128 v[136:139], v5 offset:8192
    v_mfma_f32_16x16x32_bf16 v[52:55], v[76:79], v[96:99], v[52:55]
    ds_read_b64_tr_b16 v[108:109], v7 offset:12288
    v_mfma_f32_16x16x32_bf16 v[52:55], v[84:87], v[100:103], v[52:55]
    ds_read_b64_tr_b16 v[110:111], v7 offset:12800
    v_mfma_f32_16x16x32_bf16 v[56:59], v[64:67], v[96:99], v[56:59]
    ds_read_b128 v[140:143], v5 offset:12288
    v_mfma_f32_16x16x32_bf16 v[56:59], v[72:75], v[100:103], v[56:59]
    v_mfma_f32_16x16x32_bf16 v[60:63], v[68:71], v[96:99], v[60:63]
    v_mfma_f32_16x16x32_bf16 v[60:63], v[76:79], v[100:103], v[60:63]
    s_waitcnt lgkmcnt(13)
    v_mfma_f32_16x16x32_bf16 v[32:35], v[112:115], v[128:131], v[32:35]
    s_waitcnt lgkmcnt(10)
    s_barrier
    v_mfma_f32_16x16x32_bf16 v[32:35], v[120:123], v[132:135], v[32:35]
    ds_read_b128 v[88:91], v4 offset:16384
    s_waitcnt lgkmcnt(9)
    v_mfma_f32_16x16x32_bf16 v[36:39], v[116:119], v[128:131], v[36:39]
    ds_read_b64_tr_b16 v[72:73], v6 offset:28672
    s_waitcnt lgkmcnt(8)
    v_mfma_f32_16x16x32_bf16 v[36:39], v[124:127], v[132:135], v[36:39]
    ds_read_b64_tr_b16 v[74:75], v6 offset:29184
    s_waitcnt lgkmcnt(7)
    v_mfma_f32_16x16x32_bf16 v[40:43], v[104:107], v[128:131], v[40:43]
    ds_read_b128 v[92:95], v4 offset:20480
    v_mfma_f32_16x16x32_bf16 v[40:43], v[112:115], v[132:135], v[40:43]
    ds_read_b64_tr_b16 v[80:81], v6 offset:32768
    s_waitcnt lgkmcnt(8)
    v_mfma_f32_16x16x32_bf16 v[40:43], v[120:123], v[136:139], v[40:43]
    ds_read_b64_tr_b16 v[82:83], v6 offset:33280
    s_waitcnt lgkmcnt(7)
    v_mfma_f32_16x16x32_bf16 v[44:47], v[108:111], v[128:131], v[44:47]
    ds_read_b64_tr_b16 v[76:77], v7 offset:28672
    v_mfma_f32_16x16x32_bf16 v[44:47], v[116:119], v[132:135], v[44:47]
    ds_read_b64_tr_b16 v[78:79], v7 offset:29184
    v_mfma_f32_16x16x32_bf16 v[44:47], v[124:127], v[136:139], v[44:47]
    ds_read_b64_tr_b16 v[84:85], v7 offset:32768
    v_mfma_f32_16x16x32_bf16 v[48:51], v[104:107], v[132:135], v[48:51]
    ds_read_b64_tr_b16 v[86:87], v7 offset:33280
    v_mfma_f32_16x16x32_bf16 v[48:51], v[112:115], v[136:139], v[48:51]
    ds_read_b64_tr_b16 v[64:65], v6 offset:24576
    s_waitcnt lgkmcnt(11)
    v_mfma_f32_16x16x32_bf16 v[48:51], v[120:123], v[140:143], v[48:51]
    ds_read_b64_tr_b16 v[66:67], v6 offset:25088
    v_mfma_f32_16x16x32_bf16 v[52:55], v[108:111], v[132:135], v[52:55]
    ds_read_b128 v[96:99], v4 offset:24576
    v_mfma_f32_16x16x32_bf16 v[52:55], v[116:119], v[136:139], v[52:55]
    ds_read_b64_tr_b16 v[68:69], v7 offset:24576
    v_mfma_f32_16x16x32_bf16 v[52:55], v[124:127], v[140:143], v[52:55]
    ds_read_b64_tr_b16 v[70:71], v7 offset:25088
    v_mfma_f32_16x16x32_bf16 v[56:59], v[104:107], v[136:139], v[56:59]
    ds_read_b128 v[100:103], v4 offset:28672
    v_mfma_f32_16x16x32_bf16 v[56:59], v[112:115], v[140:143], v[56:59]
    v_mfma_f32_16x16x32_bf16 v[60:63], v[108:111], v[136:139], v[60:63]
    v_mfma_f32_16x16x32_bf16 v[60:63], v[116:119], v[140:143], v[60:63]
    s_waitcnt lgkmcnt(13)
    v_mfma_f32_16x16x32_bf16 v[32:35], v[72:75], v[88:91], v[32:35]
    s_waitcnt lgkmcnt(10)
    s_barrier
    v_mfma_f32_16x16x32_bf16 v[32:35], v[80:83], v[92:95], v[32:35]
    ds_read_b128 v[128:131], v5 offset:16384
    s_waitcnt lgkmcnt(9)
    v_mfma_f32_16x16x32_bf16 v[36:39], v[76:79], v[88:91], v[36:39]
    ds_read_b64_tr_b16 v[112:113], v6 offset:40960
    s_waitcnt lgkmcnt(8)
    v_mfma_f32_16x16x32_bf16 v[36:39], v[84:87], v[92:95], v[36:39]
    ds_read_b64_tr_b16 v[114:115], v6 offset:41472
    s_waitcnt lgkmcnt(7)
    v_mfma_f32_16x16x32_bf16 v[40:43], v[64:67], v[88:91], v[40:43]
    ds_read_b128 v[132:135], v5 offset:20480
    v_mfma_f32_16x16x32_bf16 v[40:43], v[72:75], v[92:95], v[40:43]
    ds_read_b64_tr_b16 v[120:121], v6 offset:45056
    s_waitcnt lgkmcnt(8)
    v_mfma_f32_16x16x32_bf16 v[40:43], v[80:83], v[96:99], v[40:43]
    ds_read_b64_tr_b16 v[122:123], v6 offset:45568
    s_waitcnt lgkmcnt(7)
    v_mfma_f32_16x16x32_bf16 v[44:47], v[68:71], v[88:91], v[44:47]
    ds_read_b64_tr_b16 v[116:117], v7 offset:40960
    v_mfma_f32_16x16x32_bf16 v[44:47], v[76:79], v[92:95], v[44:47]
    ds_read_b64_tr_b16 v[118:119], v7 offset:41472
    v_mfma_f32_16x16x32_bf16 v[44:47], v[84:87], v[96:99], v[44:47]
    ds_read_b64_tr_b16 v[124:125], v7 offset:45056
    v_mfma_f32_16x16x32_bf16 v[48:51], v[64:67], v[92:95], v[48:51]
    ds_read_b64_tr_b16 v[126:127], v7 offset:45568
    v_mfma_f32_16x16x32_bf16 v[48:51], v[72:75], v[96:99], v[48:51]
    ds_read_b64_tr_b16 v[104:105], v6 offset:36864
    s_waitcnt lgkmcnt(11)
    v_mfma_f32_16x16x32_bf16 v[48:51], v[80:83], v[100:103], v[48:51]
    ds_read_b64_tr_b16 v[106:107], v6 offset:37376
    v_mfma_f32_16x16x32_bf16 v[52:55], v[68:71], v[92:95], v[52:55]
    ds_read_b128 v[136:139], v5 offset:24576
    v_mfma_f32_16x16x32_bf16 v[52:55], v[76:79], v[96:99], v[52:55]
    ds_read_b64_tr_b16 v[108:109], v7 offset:36864
    v_mfma_f32_16x16x32_bf16 v[52:55], v[84:87], v[100:103], v[52:55]
    ds_read_b64_tr_b16 v[110:111], v7 offset:37376
    v_mfma_f32_16x16x32_bf16 v[56:59], v[64:67], v[96:99], v[56:59]
    ds_read_b128 v[140:143], v5 offset:28672
    v_mfma_f32_16x16x32_bf16 v[56:59], v[72:75], v[100:103], v[56:59]
    v_mfma_f32_16x16x32_bf16 v[60:63], v[68:71], v[96:99], v[60:63]
    v_mfma_f32_16x16x32_bf16 v[60:63], v[76:79], v[100:103], v[60:63]
    s_waitcnt lgkmcnt(13)
    v_mfma_f32_16x16x32_bf16 v[32:35], v[112:115], v[128:131], v[32:35]
    s_waitcnt lgkmcnt(10)
    s_barrier
    v_mfma_f32_16x16x32_bf16 v[32:35], v[120:123], v[132:135], v[32:35]
    ds_read_b128 v[88:91], v4 offset:32768
    s_waitcnt lgkmcnt(9)
    v_mfma_f32_16x16x32_bf16 v[36:39], v[116:119], v[128:131], v[36:39]
    ds_read_b64_tr_b16 v[72:73], v6 offset:53248
    s_waitcnt lgkmcnt(8)
    v_mfma_f32_16x16x32_bf16 v[36:39], v[124:127], v[132:135], v[36:39]
    ds_read_b64_tr_b16 v[74:75], v6 offset:53760
    s_waitcnt lgkmcnt(7)
    v_mfma_f32_16x16x32_bf16 v[40:43], v[104:107], v[128:131], v[40:43]
    ds_read_b128 v[92:95], v4 offset:36864
    v_mfma_f32_16x16x32_bf16 v[40:43], v[112:115], v[132:135], v[40:43]
    ds_read_b64_tr_b16 v[80:81], v6 offset:57344
    s_waitcnt lgkmcnt(8)
    v_mfma_f32_16x16x32_bf16 v[40:43], v[120:123], v[136:139], v[40:43]
    ds_read_b64_tr_b16 v[82:83], v6 offset:57856
    s_waitcnt lgkmcnt(7)
    v_mfma_f32_16x16x32_bf16 v[44:47], v[108:111], v[128:131], v[44:47]
    ds_read_b64_tr_b16 v[76:77], v7 offset:53248
    v_mfma_f32_16x16x32_bf16 v[44:47], v[116:119], v[132:135], v[44:47]
    ds_read_b64_tr_b16 v[78:79], v7 offset:53760
    v_mfma_f32_16x16x32_bf16 v[44:47], v[124:127], v[136:139], v[44:47]
    ds_read_b64_tr_b16 v[84:85], v7 offset:57344
    v_mfma_f32_16x16x32_bf16 v[48:51], v[104:107], v[132:135], v[48:51]
    ds_read_b64_tr_b16 v[86:87], v7 offset:57856
    v_mfma_f32_16x16x32_bf16 v[48:51], v[112:115], v[136:139], v[48:51]
    ds_read_b64_tr_b16 v[64:65], v6 offset:49152
    s_waitcnt lgkmcnt(11)
    v_mfma_f32_16x16x32_bf16 v[48:51], v[120:123], v[140:143], v[48:51]
    ds_read_b64_tr_b16 v[66:67], v6 offset:49664
    v_mfma_f32_16x16x32_bf16 v[52:55], v[108:111], v[132:135], v[52:55]
    ds_read_b128 v[96:99], v4 offset:40960
    v_mfma_f32_16x16x32_bf16 v[52:55], v[116:119], v[136:139], v[52:55]
    ds_read_b64_tr_b16 v[68:69], v7 offset:49152
    v_mfma_f32_16x16x32_bf16 v[52:55], v[124:127], v[140:143], v[52:55]
    ds_read_b64_tr_b16 v[70:71], v7 offset:49664
    v_mfma_f32_16x16x32_bf16 v[56:59], v[104:107], v[136:139], v[56:59]
    ds_read_b128 v[100:103], v4 offset:45056
    v_mfma_f32_16x16x32_bf16 v[56:59], v[112:115], v[140:143], v[56:59]
    v_mfma_f32_16x16x32_bf16 v[60:63], v[108:111], v[136:139], v[60:63]
    v_mfma_f32_16x16x32_bf16 v[60:63], v[116:119], v[140:143], v[60:63]
    s_waitcnt lgkmcnt(13)
    v_mfma_f32_16x16x32_bf16 v[32:35], v[72:75], v[88:91], v[32:35]
    s_waitcnt lgkmcnt(10)
    s_barrier
    v_mfma_f32_16x16x32_bf16 v[32:35], v[80:83], v[92:95], v[32:35]
    ds_read_b128 v[128:131], v5 offset:32768
    s_waitcnt lgkmcnt(9)
    v_mfma_f32_16x16x32_bf16 v[36:39], v[76:79], v[88:91], v[36:39]
    ds_read_b64_tr_b16 v[112:113], v12 offset:4096
    s_waitcnt lgkmcnt(8)
    v_mfma_f32_16x16x32_bf16 v[36:39], v[84:87], v[92:95], v[36:39]
    ds_read_b64_tr_b16 v[114:115], v12 offset:4608
    s_waitcnt lgkmcnt(7)
    v_mfma_f32_16x16x32_bf16 v[40:43], v[64:67], v[88:91], v[40:43]
    ds_read_b128 v[132:135], v5 offset:36864
    v_mfma_f32_16x16x32_bf16 v[40:43], v[72:75], v[92:95], v[40:43]
    ds_read_b64_tr_b16 v[120:121], v12 offset:8192
    s_waitcnt lgkmcnt(8)
    v_mfma_f32_16x16x32_bf16 v[40:43], v[80:83], v[96:99], v[40:43]
    ds_read_b64_tr_b16 v[122:123], v12 offset:8704
    s_waitcnt lgkmcnt(7)
    v_mfma_f32_16x16x32_bf16 v[44:47], v[68:71], v[88:91], v[44:47]
    ds_read_b64_tr_b16 v[116:117], v13 offset:4096
    s_waitcnt lgkmcnt(4)
    v_mfma_f32_16x16x32_bf16 v[32:35], v[112:115], v[128:131], v[32:35]
    ds_read_b64_tr_b16 v[118:119], v13 offset:4608
    v_mfma_f32_16x16x32_bf16 v[44:47], v[76:79], v[92:95], v[44:47]
    ds_read_b64_tr_b16 v[124:125], v13 offset:8192
    v_mfma_f32_16x16x32_bf16 v[44:47], v[84:87], v[96:99], v[44:47]
    ds_read_b64_tr_b16 v[126:127], v13 offset:8704
    s_waitcnt lgkmcnt(4)
    v_mfma_f32_16x16x32_bf16 v[32:35], v[120:123], v[132:135], v[32:35]
    ds_read_b64_tr_b16 v[104:105], v12 offset:0
    v_mfma_f32_16x16x32_bf16 v[40:43], v[112:115], v[132:135], v[40:43]
    ds_read_b64_tr_b16 v[106:107], v12 offset:512
    s_waitcnt lgkmcnt(4)
    v_mfma_f32_16x16x32_bf16 v[36:39], v[116:119], v[128:131], v[36:39]
    ds_read_b128 v[136:139], v5 offset:40960
    v_mfma_f32_16x16x32_bf16 v[44:47], v[116:119], v[132:135], v[44:47]
    ds_read_b64_tr_b16 v[108:109], v13 offset:0
    s_waitcnt lgkmcnt(4)
    v_mfma_f32_16x16x32_bf16 v[36:39], v[124:127], v[132:135], v[36:39]
    ds_read_b64_tr_b16 v[110:111], v13 offset:512
    v_mfma_f32_16x16x32_bf16 v[48:51], v[64:67], v[92:95], v[48:51]
    ds_read_b128 v[140:143], v5 offset:45056
    s_waitcnt lgkmcnt(4)
    s_barrier
    v_mfma_f32_16x16x32_bf16 v[40:43], v[104:107], v[128:131], v[40:43]
    ds_read_b128 v[184:187], v4 offset:49152
    s_waitcnt lgkmcnt(4)
    v_mfma_f32_16x16x32_bf16 v[40:43], v[120:123], v[136:139], v[40:43]
    ds_read_b64_tr_b16 v[168:169], v12 offset:16384
    v_mfma_f32_16x16x32_bf16 v[44:47], v[124:127], v[136:139], v[44:47]
    ds_read_b64_tr_b16 v[170:171], v12 offset:16896
    s_waitcnt lgkmcnt(4)
    v_mfma_f32_16x16x32_bf16 v[44:47], v[108:111], v[128:131], v[44:47]
    ds_read_b128 v[188:191], v4 offset:53248
    v_mfma_f32_16x16x32_bf16 v[48:51], v[72:75], v[96:99], v[48:51]
    ds_read_b64_tr_b16 v[176:177], v12 offset:20480
    v_mfma_f32_16x16x32_bf16 v[48:51], v[80:83], v[100:103], v[48:51]
    ds_read_b64_tr_b16 v[178:179], v12 offset:20992
    v_mfma_f32_16x16x32_bf16 v[52:55], v[68:71], v[92:95], v[52:55]
    ds_read_b64_tr_b16 v[172:173], v13 offset:16384
    s_waitcnt lgkmcnt(4)
    v_mfma_f32_16x16x32_bf16 v[32:35], v[168:171], v[184:187], v[32:35]
    ds_read_b64_tr_b16 v[174:175], v13 offset:16896
    s_waitcnt lgkmcnt(4)
    v_mfma_f32_16x16x32_bf16 v[40:43], v[168:171], v[188:191], v[40:43]
    ds_read_b64_tr_b16 v[180:181], v13 offset:20480
    v_mfma_f32_16x16x32_bf16 v[52:55], v[76:79], v[96:99], v[52:55]
    ds_read_b64_tr_b16 v[182:183], v13 offset:20992
    s_waitcnt lgkmcnt(4)
    v_mfma_f32_16x16x32_bf16 v[32:35], v[176:179], v[188:191], v[32:35]
    ds_read_b64_tr_b16 v[160:161], v12 offset:12288
    v_mfma_f32_16x16x32_bf16 v[52:55], v[84:87], v[100:103], v[52:55]
    ds_read_b64_tr_b16 v[162:163], v12 offset:12800
    s_waitcnt lgkmcnt(4)
    v_mfma_f32_16x16x32_bf16 v[36:39], v[172:175], v[184:187], v[36:39]
    ds_read_b128 v[192:195], v4 offset:57344
    v_mfma_f32_16x16x32_bf16 v[44:47], v[172:175], v[188:191], v[44:47]
    ds_read_b64_tr_b16 v[164:165], v13 offset:12288
    s_waitcnt lgkmcnt(4)
    v_mfma_f32_16x16x32_bf16 v[36:39], v[180:183], v[188:191], v[36:39]
    ds_read_b64_tr_b16 v[166:167], v13 offset:12800
    v_mfma_f32_16x16x32_bf16 v[48:51], v[104:107], v[132:135], v[48:51]
    ds_read_b128 v[196:199], v4 offset:61440
    s_waitcnt lgkmcnt(4)
    s_barrier
    v_mfma_f32_16x16x32_bf16 v[40:43], v[160:163], v[184:187], v[40:43]
    ds_read_b128 v[224:227], v5 offset:49152
    s_waitcnt lgkmcnt(4)
    v_mfma_f32_16x16x32_bf16 v[40:43], v[176:179], v[192:195], v[40:43]
    ds_read_b64_tr_b16 v[208:209], v12 offset:28672
    v_mfma_f32_16x16x32_bf16 v[44:47], v[180:183], v[192:195], v[44:47]
    ds_read_b64_tr_b16 v[210:211], v12 offset:29184
    s_waitcnt lgkmcnt(4)
    v_mfma_f32_16x16x32_bf16 v[44:47], v[164:167], v[184:187], v[44:47]
    ds_read_b128 v[228:231], v5 offset:53248
    v_mfma_f32_16x16x32_bf16 v[48:51], v[112:115], v[136:139], v[48:51]
    ds_read_b64_tr_b16 v[216:217], v12 offset:32768
    v_mfma_f32_16x16x32_bf16 v[48:51], v[120:123], v[140:143], v[48:51]
    ds_read_b64_tr_b16 v[218:219], v12 offset:33280
    v_mfma_f32_16x16x32_bf16 v[52:55], v[108:111], v[132:135], v[52:55]
    ds_read_b64_tr_b16 v[212:213], v13 offset:28672
    s_waitcnt lgkmcnt(4)
    v_mfma_f32_16x16x32_bf16 v[32:35], v[208:211], v[224:227], v[32:35]
    ds_read_b64_tr_b16 v[214:215], v13 offset:29184
    s_waitcnt lgkmcnt(4)
    v_mfma_f32_16x16x32_bf16 v[40:43], v[208:211], v[228:231], v[40:43]
    ds_read_b64_tr_b16 v[220:221], v13 offset:32768
    v_mfma_f32_16x16x32_bf16 v[52:55], v[116:119], v[136:139], v[52:55]
    ds_read_b64_tr_b16 v[222:223], v13 offset:33280
    s_waitcnt lgkmcnt(4)
    v_mfma_f32_16x16x32_bf16 v[32:35], v[216:219], v[228:231], v[32:35]
    ds_read_b64_tr_b16 v[200:201], v12 offset:24576
    v_mfma_f32_16x16x32_bf16 v[52:55], v[124:127], v[140:143], v[52:55]
    ds_read_b64_tr_b16 v[202:203], v12 offset:25088
    s_waitcnt lgkmcnt(4)
    v_mfma_f32_16x16x32_bf16 v[36:39], v[212:215], v[224:227], v[36:39]
    ds_read_b128 v[232:235], v5 offset:57344
    v_mfma_f32_16x16x32_bf16 v[44:47], v[212:215], v[228:231], v[44:47]
    ds_read_b64_tr_b16 v[204:205], v13 offset:24576
    s_waitcnt lgkmcnt(4)
    v_mfma_f32_16x16x32_bf16 v[36:39], v[220:223], v[228:231], v[36:39]
    ds_read_b64_tr_b16 v[206:207], v13 offset:25088
    v_mfma_f32_16x16x32_bf16 v[48:51], v[160:163], v[188:191], v[48:51]
    ds_read_b128 v[236:239], v5 offset:61440
    s_waitcnt lgkmcnt(4)
    v_mfma_f32_16x16x32_bf16 v[40:43], v[200:203], v[224:227], v[40:43]
    s_waitcnt lgkmcnt(3)
    v_mfma_f32_16x16x32_bf16 v[40:43], v[216:219], v[232:235], v[40:43]
    v_mfma_f32_16x16x32_bf16 v[44:47], v[220:223], v[232:235], v[44:47]
    s_waitcnt lgkmcnt(1)
    v_mfma_f32_16x16x32_bf16 v[44:47], v[204:207], v[224:227], v[44:47]
    v_fma_f32 v32, v32, v144, v152
    v_fma_f32 v33, v33, v145, v153
    v_fma_f32 v34, v34, v146, v154
    v_fma_f32 v35, v35, v147, v155
    v_mfma_f32_16x16x32_bf16 v[48:51], v[168:171], v[192:195], v[48:51]
    v_fma_f32 v36, v36, v148, v156
    v_fma_f32 v37, v37, v149, v157
    v_fma_f32 v38, v38, v150, v158
    v_fma_f32 v39, v39, v151, v159
    v_mfma_f32_16x16x32_bf16 v[48:51], v[176:179], v[196:199], v[48:51]
    v_exp_f32 v240, v32
    v_exp_f32 v241, v33
    v_mfma_f32_16x16x32_bf16 v[52:55], v[164:167], v[188:191], v[52:55]
    v_exp_f32 v242, v34
    v_exp_f32 v243, v35
    v_mfma_f32_16x16x32_bf16 v[52:55], v[172:175], v[192:195], v[52:55]
    v_exp_f32 v244, v36
    v_exp_f32 v245, v37
    v_mfma_f32_16x16x32_bf16 v[52:55], v[180:183], v[196:199], v[52:55]
    v_exp_f32 v246, v38
    v_exp_f32 v247, v39
    v_mfma_f32_16x16x32_bf16 v[48:51], v[200:203], v[228:231], v[48:51]
    v_fma_f32 v240, v240, s18, s18
    v_fma_f32 v241, v241, s18, s18
    v_fma_f32 v242, v242, s18, s18
    v_fma_f32 v243, v243, s18, s18
    v_mfma_f32_16x16x32_bf16 v[48:51], v[208:211], v[232:235], v[48:51]
    v_fma_f32 v244, v244, s18, s18
    v_fma_f32 v245, v245, s18, s18
    v_fma_f32 v246, v246, s18, s18
    v_fma_f32 v247, v247, s18, s18
    s_waitcnt lgkmcnt(0)
    v_mfma_f32_16x16x32_bf16 v[48:51], v[216:219], v[236:239], v[48:51]
    v_rcp_f32 v240, v240
    v_rcp_f32 v241, v241
    v_mfma_f32_16x16x32_bf16 v[52:55], v[204:207], v[228:231], v[52:55]
    v_rcp_f32 v242, v242
    v_rcp_f32 v243, v243
    v_mfma_f32_16x16x32_bf16 v[52:55], v[212:215], v[232:235], v[52:55]
    v_rcp_f32 v244, v244
    v_rcp_f32 v245, v245
    v_mfma_f32_16x16x32_bf16 v[52:55], v[220:223], v[236:239], v[52:55]
    v_rcp_f32 v246, v246
    v_rcp_f32 v247, v247
    v_mfma_f32_16x16x32_bf16 v[56:59], v[64:67], v[96:99], v[56:59]
    v_mul_f32 v32, v32, v240
    v_mul_f32 v33, v33, v241
    v_mul_f32 v34, v34, v242
    v_mul_f32 v35, v35, v243
    v_mfma_f32_16x16x32_bf16 v[56:59], v[72:75], v[100:103], v[56:59]
    v_mul_f32 v36, v36, v244
    v_mul_f32 v37, v37, v245
    v_mul_f32 v38, v38, v246
    v_mul_f32 v39, v39, v247
    v_mfma_f32_16x16x32_bf16 v[60:63], v[68:71], v[96:99], v[60:63]
    v_cvt_pk_bf16_f32 v32, v32, v33
    v_cvt_pk_bf16_f32 v33, v34, v35
    v_cvt_pk_bf16_f32 v34, v36, v37
    v_cvt_pk_bf16_f32 v35, v38, v39
    v_mfma_f32_16x16x32_bf16 v[60:63], v[76:79], v[100:103], v[60:63]
    s_nop 1
    v_permlane16_swap_b32 v32, v34
    v_permlane16_swap_b32 v33, v35
    buffer_store_dwordx4 v[32:35], v19, s[52:55], 0 offen offset:0 sc0 sc1
    v_mfma_f32_16x16x32_bf16 v[56:59], v[104:107], v[136:139], v[56:59]
    v_fma_f32 v40, v40, v144, v152
    v_fma_f32 v41, v41, v145, v153
    v_fma_f32 v42, v42, v146, v154
    v_fma_f32 v43, v43, v147, v155
    v_mfma_f32_16x16x32_bf16 v[56:59], v[112:115], v[140:143], v[56:59]
    v_fma_f32 v44, v44, v148, v156
    v_fma_f32 v45, v45, v149, v157
    v_fma_f32 v46, v46, v150, v158
    v_fma_f32 v47, v47, v151, v159
    v_mfma_f32_16x16x32_bf16 v[60:63], v[108:111], v[136:139], v[60:63]
    v_exp_f32 v248, v40
    v_exp_f32 v249, v41
    v_mfma_f32_16x16x32_bf16 v[60:63], v[116:119], v[140:143], v[60:63]
    v_exp_f32 v250, v42
    v_exp_f32 v251, v43
    v_mfma_f32_16x16x32_bf16 v[56:59], v[160:163], v[192:195], v[56:59]
    v_exp_f32 v252, v44
    v_exp_f32 v253, v45
    v_mfma_f32_16x16x32_bf16 v[56:59], v[168:171], v[196:199], v[56:59]
    v_exp_f32 v254, v46
    v_exp_f32 v255, v47
    v_mfma_f32_16x16x32_bf16 v[60:63], v[164:167], v[192:195], v[60:63]
    v_fma_f32 v248, v248, s18, s18
    v_fma_f32 v249, v249, s18, s18
    v_fma_f32 v250, v250, s18, s18
    v_fma_f32 v251, v251, s18, s18
    v_mfma_f32_16x16x32_bf16 v[60:63], v[172:175], v[196:199], v[60:63]
    v_fma_f32 v252, v252, s18, s18
    v_fma_f32 v253, v253, s18, s18
    v_fma_f32 v254, v254, s18, s18
    v_fma_f32 v255, v255, s18, s18
    v_mfma_f32_16x16x32_bf16 v[56:59], v[200:203], v[232:235], v[56:59]
    v_rcp_f32 v248, v248
    v_rcp_f32 v249, v249
    v_mfma_f32_16x16x32_bf16 v[56:59], v[208:211], v[236:239], v[56:59]
    v_rcp_f32 v250, v250
    v_rcp_f32 v251, v251
    v_mfma_f32_16x16x32_bf16 v[60:63], v[204:207], v[232:235], v[60:63]
    v_rcp_f32 v252, v252
    v_rcp_f32 v253, v253
    v_mfma_f32_16x16x32_bf16 v[60:63], v[212:215], v[236:239], v[60:63]
    v_rcp_f32 v254, v254
    v_rcp_f32 v255, v255
    v_mul_f32 v40, v40, v248
    v_mul_f32 v41, v41, v249
    v_mul_f32 v42, v42, v250
    v_mul_f32 v43, v43, v251
    v_mul_f32 v44, v44, v252
    v_mul_f32 v45, v45, v253
    v_mul_f32 v46, v46, v254
    v_mul_f32 v47, v47, v255
    v_cvt_pk_bf16_f32 v40, v40, v41
    v_cvt_pk_bf16_f32 v41, v42, v43
    v_cvt_pk_bf16_f32 v42, v44, v45
    v_cvt_pk_bf16_f32 v43, v46, v47
    s_nop 1
    v_permlane16_swap_b32 v40, v42
    v_permlane16_swap_b32 v41, v43
    buffer_store_dwordx4 v[40:43], v19, s[52:55], 0 offen offset:1024 sc0 sc1
    v_pk_fma_f32 v[48:49], v[48:49], v[144:145], v[152:153]
    v_pk_fma_f32 v[50:51], v[50:51], v[146:147], v[154:155]
    v_pk_fma_f32 v[52:53], v[52:53], v[148:149], v[156:157]
    v_pk_fma_f32 v[54:55], v[54:55], v[150:151], v[158:159]
    v_exp_f32 v80, v48
    v_exp_f32 v81, v49
    v_exp_f32 v82, v50
    v_exp_f32 v83, v51
    v_exp_f32 v84, v52
    v_exp_f32 v85, v53
    v_exp_f32 v86, v54
    v_exp_f32 v87, v55
    v_pk_fma_f32 v[80:81], v[80:81], s[18:19], s[18:19]
    v_pk_fma_f32 v[82:83], v[82:83], s[18:19], s[18:19]
    v_pk_fma_f32 v[84:85], v[84:85], s[18:19], s[18:19]
    v_pk_fma_f32 v[86:87], v[86:87], s[18:19], s[18:19]
    v_rcp_f32 v80, v80
    v_rcp_f32 v81, v81
    v_rcp_f32 v82, v82
    v_rcp_f32 v83, v83
    v_rcp_f32 v84, v84
    v_rcp_f32 v85, v85
    v_rcp_f32 v86, v86
    v_rcp_f32 v87, v87
    v_pk_mul_f32 v[48:49], v[48:49], v[80:81]
    v_pk_mul_f32 v[50:51], v[50:51], v[82:83]
    v_pk_mul_f32 v[52:53], v[52:53], v[84:85]
    v_pk_mul_f32 v[54:55], v[54:55], v[86:87]
    v_cvt_pk_bf16_f32 v48, v48, v49
    v_cvt_pk_bf16_f32 v49, v50, v51
    v_cvt_pk_bf16_f32 v50, v52, v53
    v_cvt_pk_bf16_f32 v51, v54, v55
    v_pk_fma_f32 v[56:57], v[56:57], v[144:145], v[152:153]
    v_pk_fma_f32 v[58:59], v[58:59], v[146:147], v[154:155]
    v_pk_fma_f32 v[60:61], v[60:61], v[148:149], v[156:157]
    v_pk_fma_f32 v[62:63], v[62:63], v[150:151], v[158:159]
    v_permlane16_swap_b32 v48, v50
    v_permlane16_swap_b32 v49, v51
    buffer_store_dwordx4 v[48:51], v19, s[52:55], 0 offen offset:2048 sc0 sc1
    v_exp_f32 v88, v56
    v_exp_f32 v89, v57
    v_exp_f32 v90, v58
    v_exp_f32 v91, v59
    v_exp_f32 v92, v60
    v_exp_f32 v93, v61
    v_exp_f32 v94, v62
    v_exp_f32 v95, v63
    v_pk_fma_f32 v[88:89], v[88:89], s[18:19], s[18:19]
    v_pk_fma_f32 v[90:91], v[90:91], s[18:19], s[18:19]
    v_pk_fma_f32 v[92:93], v[92:93], s[18:19], s[18:19]
    v_pk_fma_f32 v[94:95], v[94:95], s[18:19], s[18:19]
    v_rcp_f32 v88, v88
    v_rcp_f32 v89, v89
    v_rcp_f32 v90, v90
    v_rcp_f32 v91, v91
    v_rcp_f32 v92, v92
    v_rcp_f32 v93, v93
    v_rcp_f32 v94, v94
    v_rcp_f32 v95, v95
    v_pk_mul_f32 v[56:57], v[56:57], v[88:89]
    v_pk_mul_f32 v[58:59], v[58:59], v[90:91]
    v_pk_mul_f32 v[60:61], v[60:61], v[92:93]
    v_pk_mul_f32 v[62:63], v[62:63], v[94:95]
    v_cvt_pk_bf16_f32 v56, v56, v57
    v_cvt_pk_bf16_f32 v57, v58, v59
    v_cvt_pk_bf16_f32 v58, v60, v61
    v_cvt_pk_bf16_f32 v59, v62, v63
    s_nop 1
    v_permlane16_swap_b32 v56, v58
    v_permlane16_swap_b32 v57, v59
    buffer_store_dwordx4 v[56:59], v19, s[52:55], 0 offen offset:3072 sc0 sc1
L_end:
    s_endpgm
.section .rodata,"a"
.p2align 6
.amdhsa_kernel standalone__batchnorm__sampling_kernel
  .amdhsa_next_free_vgpr 256
  .amdhsa_next_free_sgpr 96
  .amdhsa_accum_offset 256
  .amdhsa_group_segment_fixed_size 0
  .amdhsa_kernarg_size 72
  .amdhsa_user_sgpr_count 2
  .amdhsa_user_sgpr_kernarg_segment_ptr 1
  .amdhsa_system_sgpr_workgroup_id_x 1
.end_amdhsa_kernel
```
